```python
import torch

def _softmax(x, axis=-1):
    return torch.softmax(x, dim=axis)
def _gelu(x):
    return torch.nn.functional.gelu(x, approximate="tanh")
def _silu(x):
    return torch.nn.functional.silu(x)
def _sigmoid(x):
    return torch.sigmoid(x)
def _layernorm(x, axis=-1, eps=1e-5):
    m = x.mean(dim=axis, keepdim=True)
    v = x.var(dim=axis, keepdim=True, unbiased=False)
    return (x - m) / torch.sqrt(v + eps)
def _scatter_add(tgt, idx, src, axis=0):
    return tgt.clone().index_add_(axis, idx, src)
def _segment_sum(src, seg, n):
    out = torch.zeros((n,) + src.shape[1:], dtype=src.dtype)
    return out.index_add_(0, seg, src)
def _pad(x, pw):
    flat = tuple(v for pair in reversed(pw) for v in pair)
    return torch.nn.functional.pad(x, flat)

kernel_name = 'standalone__groupnorm__sampling'

def setup_inputs():

    _w = (lambda a: (lambda t: t.to(torch.bfloat16) if t.is_floating_point() else t)(torch.as_tensor(a)))
    B = 32
    G = 32
    cpg = max(1, 1024 // G)
    C = G * cpg
    H, W = 32, 16
    return {
        "x": _w(abs((lambda *s: torch.randn(*s, dtype=torch.bfloat16) * 0.05)(B, C, H, W))),
        "g": _w((lambda *s: torch.randn(*s, dtype=torch.bfloat16) * 0.05)(C) + 1.0),
        "b": _w((lambda *s: torch.randn(*s, dtype=torch.bfloat16) * 0.4)(C)),
    }

def reference(x, g, b):
    G = 32
    B, C, H, W = x.shape[0], x.shape[1], x.shape[2], x.shape[3]
    xr = x.reshape(B, G, C // G, H, W)
    mu = xr.mean(axis=(2, 3, 4), keepdims=True)
    var = ((xr - mu) ** 2).mean(axis=(2, 3, 4), keepdims=True)
    xn = (xr - mu) / torch.sqrt(var + 1e-5)
    xn = xn.reshape(B, C, H, W)
    return xn * g[None, :, None, None] + b[None, :, None, None]
```

```asm
; @launch grid=(1024,1,1) block=(512,1,1) lds=8320
.amdgcn_target "amdgcn-amd-amdhsa--gfx950"
.text
.globl standalone__groupnorm__sampling_kernel
.p2align 8
.type standalone__groupnorm__sampling_kernel,@function
standalone__groupnorm__sampling_kernel:
    s_load_dwordx2 s[4:5], s[0:1], 0
    s_cmpk_ge_u32 s2, 0x400
    s_cbranch_scc1 L_end
    v_readfirstlane_b32 s12, v0
    s_lshl_b32 s14, s2, 15
    s_setprio 3
    s_mul_i32 s15, s12, 48
    s_add_u32 s15, s15, s14
    v_lshl_add_u32 v1, v0, 4, s15
    s_waitcnt lgkmcnt(0)
    global_load_dwordx4 v[24:27], v1, s[4:5] offset:0 nt
    global_load_dwordx4 v[32:35], v1, s[4:5] offset:1024 nt
    global_load_dwordx4 v[40:43], v1, s[4:5] offset:2048 nt
    global_load_dwordx4 v[48:51], v1, s[4:5] offset:3072 nt
    s_setprio 0
    s_load_dwordx2 s[6:7], s[0:1], 8
    s_load_dwordx4 s[8:11], s[0:1], 16
    s_and_b32 s13, s2, 31
    s_lshl_b32 s13, s13, 6
    s_lshr_b32 s3, s12, 3
    s_add_u32 s13, s13, s3
    s_lshr_b32 s3, s12, 2
    v_and_b32 v3, 63, v0
    v_cmp_eq_u32 vcc, 63, v3
    v_add_lshl_u32 v2, v0, 8, 4
    v_mov_b32 v12, s3
    v_and_b32 v3, 7, v0
    v_cndmask_b32 v2, v2, v12, vcc
    v_lshlrev_b32 v3, 4, v3
    s_mov_b32 s28, 0x38800000
    s_mov_b32 s29, 0x3727c5ac
    s_mov_b32 s30, 0xffff0000
    s_mov_b32 s31, 0x45000000
    s_waitcnt vmcnt(3)
    v_readfirstlane_b32 s26, v24
    s_waitcnt lgkmcnt(0)
    s_load_dwordx2 s[16:17], s[6:7], s13
    s_load_dwordx2 s[20:21], s[8:9], s13
    v_lshlrev_b32 v20, 16, v24
    v_and_b32 v21, s30, v24
    v_lshlrev_b32 v22, 16, v25
    v_and_b32 v23, s30, v25
    s_lshl_b32 s26, s26, 16
    v_lshlrev_b32 v24, 16, v26
    v_and_b32 v25, s30, v26
    v_lshlrev_b32 v26, 16, v27
    v_and_b32 v27, s30, v27
    v_pk_add_f32 v[20:21], v[20:21], s[26:27] op_sel_hi:[1,0] neg_lo:[0,1] neg_hi:[0,1]
    v_pk_add_f32 v[22:23], v[22:23], s[26:27] op_sel_hi:[1,0] neg_lo:[0,1] neg_hi:[0,1]
    v_pk_add_f32 v[24:25], v[24:25], s[26:27] op_sel_hi:[1,0] neg_lo:[0,1] neg_hi:[0,1]
    v_pk_add_f32 v[26:27], v[26:27], s[26:27] op_sel_hi:[1,0] neg_lo:[0,1] neg_hi:[0,1]
    v_mov_b32 v14, s26
    v_pk_mul_f32 v[6:7], v[20:21], v[20:21]
    v_pk_mul_f32 v[10:11], v[22:23], v[22:23]
    v_pk_add_f32 v[4:5], v[20:21], v[24:25]
    v_pk_fma_f32 v[6:7], v[24:25], v[24:25], v[6:7]
    v_pk_add_f32 v[8:9], v[22:23], v[26:27]
    v_pk_fma_f32 v[10:11], v[26:27], v[26:27], v[10:11]
    s_waitcnt vmcnt(2)
    v_lshlrev_b32 v28, 16, v32
    v_and_b32 v29, s30, v32
    v_lshlrev_b32 v30, 16, v33
    v_and_b32 v31, s30, v33
    v_lshlrev_b32 v32, 16, v34
    v_and_b32 v33, s30, v34
    v_lshlrev_b32 v34, 16, v35
    v_and_b32 v35, s30, v35
    v_pk_add_f32 v[28:29], v[28:29], s[26:27] op_sel_hi:[1,0] neg_lo:[0,1] neg_hi:[0,1]
    v_pk_add_f32 v[30:31], v[30:31], s[26:27] op_sel_hi:[1,0] neg_lo:[0,1] neg_hi:[0,1]
    v_pk_add_f32 v[32:33], v[32:33], s[26:27] op_sel_hi:[1,0] neg_lo:[0,1] neg_hi:[0,1]
    v_pk_add_f32 v[34:35], v[34:35], s[26:27] op_sel_hi:[1,0] neg_lo:[0,1] neg_hi:[0,1]
    v_pk_add_f32 v[4:5], v[4:5], v[28:29]
    v_pk_fma_f32 v[6:7], v[28:29], v[28:29], v[6:7]
    v_pk_add_f32 v[8:9], v[8:9], v[30:31]
    v_pk_fma_f32 v[10:11], v[30:31], v[30:31], v[10:11]
    v_pk_add_f32 v[4:5], v[4:5], v[32:33]
    v_pk_fma_f32 v[6:7], v[32:33], v[32:33], v[6:7]
    v_pk_add_f32 v[8:9], v[8:9], v[34:35]
    v_pk_fma_f32 v[10:11], v[34:35], v[34:35], v[10:11]
    s_waitcnt vmcnt(1)
    v_lshlrev_b32 v36, 16, v40
    v_and_b32 v37, s30, v40
    v_lshlrev_b32 v38, 16, v41
    v_and_b32 v39, s30, v41
    v_lshlrev_b32 v40, 16, v42
    v_and_b32 v41, s30, v42
    v_lshlrev_b32 v42, 16, v43
    v_and_b32 v43, s30, v43
    v_pk_add_f32 v[36:37], v[36:37], s[26:27] op_sel_hi:[1,0] neg_lo:[0,1] neg_hi:[0,1]
    v_pk_add_f32 v[38:39], v[38:39], s[26:27] op_sel_hi:[1,0] neg_lo:[0,1] neg_hi:[0,1]
    v_pk_add_f32 v[40:41], v[40:41], s[26:27] op_sel_hi:[1,0] neg_lo:[0,1] neg_hi:[0,1]
    v_pk_add_f32 v[42:43], v[42:43], s[26:27] op_sel_hi:[1,0] neg_lo:[0,1] neg_hi:[0,1]
    v_pk_add_f32 v[4:5], v[4:5], v[36:37]
    v_pk_fma_f32 v[6:7], v[36:37], v[36:37], v[6:7]
    v_pk_add_f32 v[8:9], v[8:9], v[38:39]
    v_pk_fma_f32 v[10:11], v[38:39], v[38:39], v[10:11]
    v_pk_add_f32 v[4:5], v[4:5], v[40:41]
    v_pk_fma_f32 v[6:7], v[40:41], v[40:41], v[6:7]
    v_pk_add_f32 v[8:9], v[8:9], v[42:43]
    v_pk_fma_f32 v[10:11], v[42:43], v[42:43], v[10:11]
    s_waitcnt vmcnt(0)
    v_lshlrev_b32 v44, 16, v48
    v_and_b32 v45, s30, v48
    v_lshlrev_b32 v46, 16, v49
    v_and_b32 v47, s30, v49
    v_lshlrev_b32 v48, 16, v50
    v_and_b32 v49, s30, v50
    v_lshlrev_b32 v50, 16, v51
    v_and_b32 v51, s30, v51
    v_pk_add_f32 v[44:45], v[44:45], s[26:27] op_sel_hi:[1,0] neg_lo:[0,1] neg_hi:[0,1]
    v_pk_add_f32 v[46:47], v[46:47], s[26:27] op_sel_hi:[1,0] neg_lo:[0,1] neg_hi:[0,1]
    v_pk_add_f32 v[48:49], v[48:49], s[26:27] op_sel_hi:[1,0] neg_lo:[0,1] neg_hi:[0,1]
    v_pk_add_f32 v[50:51], v[50:51], s[26:27] op_sel_hi:[1,0] neg_lo:[0,1] neg_hi:[0,1]
    v_pk_add_f32 v[4:5], v[4:5], v[44:45]
    v_pk_fma_f32 v[6:7], v[44:45], v[44:45], v[6:7]
    v_pk_add_f32 v[8:9], v[8:9], v[46:47]
    v_pk_fma_f32 v[10:11], v[46:47], v[46:47], v[10:11]
    v_pk_add_f32 v[4:5], v[4:5], v[48:49]
    v_pk_fma_f32 v[6:7], v[48:49], v[48:49], v[6:7]
    v_pk_add_f32 v[8:9], v[8:9], v[50:51]
    v_pk_fma_f32 v[10:11], v[50:51], v[50:51], v[10:11]
    v_pk_add_f32 v[4:5], v[4:5], v[8:9]
    v_pk_add_f32 v[6:7], v[6:7], v[10:11]
    v_add_f32 v12, v4, v5
    v_add_f32 v13, v6, v7
    s_nop 0
    v_add_f32_dpp v12, v12, v12 row_shr:1 row_mask:0xf bank_mask:0xf
    v_add_f32_dpp v13, v13, v13 row_shr:1 row_mask:0xf bank_mask:0xf
    s_nop 0
    v_add_f32_dpp v12, v12, v12 row_shr:2 row_mask:0xf bank_mask:0xf
    v_add_f32_dpp v13, v13, v13 row_shr:2 row_mask:0xf bank_mask:0xf
    s_nop 0
    v_add_f32_dpp v12, v12, v12 row_shr:4 row_mask:0xf bank_mask:0xf
    v_add_f32_dpp v13, v13, v13 row_shr:4 row_mask:0xf bank_mask:0xf
    s_nop 0
    v_add_f32_dpp v12, v12, v12 row_shr:8 row_mask:0xf bank_mask:0xf
    v_add_f32_dpp v13, v13, v13 row_shr:8 row_mask:0xf bank_mask:0xf
    s_nop 0
    v_add_f32_dpp v12, v12, v12 row_bcast:15 row_mask:0xa bank_mask:0xf
    v_add_f32_dpp v13, v13, v13 row_bcast:15 row_mask:0xa bank_mask:0xf
    s_nop 0
    v_add_f32_dpp v12, v12, v12 row_bcast:31 row_mask:0xc bank_mask:0xf
    v_add_f32_dpp v13, v13, v13 row_bcast:31 row_mask:0xc bank_mask:0xf
    ds_write_b96 v2, v[12:14]
    s_waitcnt lgkmcnt(0)
    s_lshl_b32 s32, s16, 16
    s_lshl_b32 s40, s20, 16
    s_and_b32 s33, s16, s30
    s_and_b32 s41, s20, s30
    s_lshl_b32 s34, s17, 16
    s_lshl_b32 s42, s21, 16
    s_and_b32 s35, s17, s30
    s_and_b32 s43, s21, s30
    s_barrier
    ds_read_b96 v[12:14], v3
    s_waitcnt lgkmcnt(0)
    v_subrev_f32 v14, s26, v14
    v_fma_f32 v15, v14, s31, v12
    v_add_f32 v12, v12, v15
    v_fma_f32 v13, v14, v12, v13
    v_mov_b32 v12, v15
    s_nop 0
    v_add_f32_dpp v13, v13, v13 quad_perm:[1,0,3,2] row_mask:0xf bank_mask:0xf
    v_add_f32_dpp v12, v12, v12 quad_perm:[1,0,3,2] row_mask:0xf bank_mask:0xf
    s_nop 0
    v_add_f32_dpp v13, v13, v13 quad_perm:[2,3,0,1] row_mask:0xf bank_mask:0xf
    v_add_f32_dpp v12, v12, v12 quad_perm:[2,3,0,1] row_mask:0xf bank_mask:0xf
    s_nop 0
    v_add_f32_dpp v13, v13, v13 row_half_mirror row_mask:0xf bank_mask:0xf
    v_add_f32_dpp v12, v12, v12 row_half_mirror row_mask:0xf bank_mask:0xf
    v_pk_mul_f32 v[12:13], v[12:13], s[28:29] op_sel_hi:[1,0]
    v_fma_f32 v13, -v12, v12, v13
    v_add_f32 v13, s29, abs(v13)
    v_rsq_f32 v13, v13
    s_nop 0
    v_mul_f32 v14, s32, v13
    v_fma_f32 v15, -v12, v14, s40
    v_pk_fma_f32 v[20:21], v[20:21], v[14:15], v[14:15] op_sel:[0,0,1] op_sel_hi:[1,0,1]
    v_pk_fma_f32 v[22:23], v[22:23], v[14:15], v[14:15] op_sel:[0,0,1] op_sel_hi:[1,0,1]
    v_pk_fma_f32 v[24:25], v[24:25], v[14:15], v[14:15] op_sel:[0,0,1] op_sel_hi:[1,0,1]
    v_pk_fma_f32 v[26:27], v[26:27], v[14:15], v[14:15] op_sel:[0,0,1] op_sel_hi:[1,0,1]
    v_cvt_pk_bf16_f32 v20, v20, v21
    v_cvt_pk_bf16_f32 v21, v22, v23
    v_cvt_pk_bf16_f32 v22, v24, v25
    v_cvt_pk_bf16_f32 v23, v26, v27
    global_store_dwordx4 v1, v[20:23], s[10:11] offset:0 sc1
    v_mul_f32 v16, s33, v13
    v_fma_f32 v17, -v12, v16, s41
    v_pk_fma_f32 v[28:29], v[28:29], v[16:17], v[16:17] op_sel:[0,0,1] op_sel_hi:[1,0,1]
    v_pk_fma_f32 v[30:31], v[30:31], v[16:17], v[16:17] op_sel:[0,0,1] op_sel_hi:[1,0,1]
    v_pk_fma_f32 v[32:33], v[32:33], v[16:17], v[16:17] op_sel:[0,0,1] op_sel_hi:[1,0,1]
    v_pk_fma_f32 v[34:35], v[34:35], v[16:17], v[16:17] op_sel:[0,0,1] op_sel_hi:[1,0,1]
    v_cvt_pk_bf16_f32 v28, v28, v29
    v_cvt_pk_bf16_f32 v29, v30, v31
    v_cvt_pk_bf16_f32 v30, v32, v33
    v_cvt_pk_bf16_f32 v31, v34, v35
    global_store_dwordx4 v1, v[28:31], s[10:11] offset:1024 sc1
    v_mul_f32 v14, s34, v13
    v_fma_f32 v15, -v12, v14, s42
    v_pk_fma_f32 v[36:37], v[36:37], v[14:15], v[14:15] op_sel:[0,0,1] op_sel_hi:[1,0,1]
    v_pk_fma_f32 v[38:39], v[38:39], v[14:15], v[14:15] op_sel:[0,0,1] op_sel_hi:[1,0,1]
    v_pk_fma_f32 v[40:41], v[40:41], v[14:15], v[14:15] op_sel:[0,0,1] op_sel_hi:[1,0,1]
    v_pk_fma_f32 v[42:43], v[42:43], v[14:15], v[14:15] op_sel:[0,0,1] op_sel_hi:[1,0,1]
    v_cvt_pk_bf16_f32 v36, v36, v37
    v_cvt_pk_bf16_f32 v37, v38, v39
    v_cvt_pk_bf16_f32 v38, v40, v41
    v_cvt_pk_bf16_f32 v39, v42, v43
    global_store_dwordx4 v1, v[36:39], s[10:11] offset:2048 sc1
    v_mul_f32 v16, s35, v13
    v_fma_f32 v17, -v12, v16, s43
    v_pk_fma_f32 v[44:45], v[44:45], v[16:17], v[16:17] op_sel:[0,0,1] op_sel_hi:[1,0,1]
    v_pk_fma_f32 v[46:47], v[46:47], v[16:17], v[16:17] op_sel:[0,0,1] op_sel_hi:[1,0,1]
    v_pk_fma_f32 v[48:49], v[48:49], v[16:17], v[16:17] op_sel:[0,0,1] op_sel_hi:[1,0,1]
    v_pk_fma_f32 v[50:51], v[50:51], v[16:17], v[16:17] op_sel:[0,0,1] op_sel_hi:[1,0,1]
    v_cvt_pk_bf16_f32 v44, v44, v45
    v_cvt_pk_bf16_f32 v45, v46, v47
    v_cvt_pk_bf16_f32 v46, v48, v49
    v_cvt_pk_bf16_f32 v47, v50, v51
    global_store_dwordx4 v1, v[44:47], s[10:11] offset:3072 sc1
L_end:
    s_endpgm
.section .rodata,"a"
.p2align 6
.amdhsa_kernel standalone__groupnorm__sampling_kernel
  .amdhsa_next_free_vgpr 52
  .amdhsa_next_free_sgpr 48
  .amdhsa_accum_offset 52
  .amdhsa_group_segment_fixed_size 0
  .amdhsa_kernarg_size 48
  .amdhsa_user_sgpr_count 2
  .amdhsa_user_sgpr_kernarg_segment_ptr 1
  .amdhsa_system_sgpr_workgroup_id_x 1
  .amdhsa_float_denorm_mode_32 3
.end_amdhsa_kernel
```
